```python
import torch

def _softmax(x, axis=-1):
    return torch.softmax(x, dim=axis)
def _gelu(x):
    return torch.nn.functional.gelu(x, approximate="tanh")
def _silu(x):
    return torch.nn.functional.silu(x)
def _sigmoid(x):
    return torch.sigmoid(x)
def _layernorm(x, axis=-1, eps=1e-5):
    m = x.mean(dim=axis, keepdim=True)
    v = x.var(dim=axis, keepdim=True, unbiased=False)
    return (x - m) / torch.sqrt(v + eps)
def _scatter_add(tgt, idx, src, axis=0):
    return tgt.clone().index_add_(axis, idx, src)
def _segment_sum(src, seg, n):
    out = torch.zeros((n,) + src.shape[1:], dtype=src.dtype)
    return out.index_add_(0, seg, src)
def _pad(x, pw):
    flat = tuple(v for pair in reversed(pw) for v in pair)
    return torch.nn.functional.pad(x, flat)

kernel_name = 'standalone__fused_bias_dropout_add__prompt'

def setup_inputs():

    _w = (lambda a: (lambda t: t.to(torch.bfloat16) if t.is_floating_point() else t)(torch.as_tensor(a)))
    B, S, D = 2, 2048, 1024
    keep = 0.9
    mask = (torch.rand(B, S, D) < keep).to(float)
    return {
        "x": _w((lambda *s: torch.randn(*s, dtype=torch.bfloat16) * 0.05)(B, S, D)),
        "bias": _w((lambda *s: torch.randn(*s, dtype=torch.bfloat16) * 0.05)(D)),
        "mask": _w(mask),
        "residual": _w((lambda *s: torch.randn(*s, dtype=torch.bfloat16) * 0.05)(B, S, D)),
    }

def reference(x, bias, mask, residual):
    keep = 0.9
    return residual + (x + bias) * mask * (1.0 / keep)
```

```asm
; @launch grid=(512,1,1) block=(1024,1,1) lds=0
.amdgcn_target "amdgcn-amd-amdhsa--gfx950"
.text
.globl standalone__fused_bias_dropout_add__prompt_kernel
.p2align 8
.type standalone__fused_bias_dropout_add__prompt_kernel,@function
standalone__fused_bias_dropout_add__prompt_kernel:
    s_load_dwordx8 s[4:11], s[0:1], 0
    s_load_dwordx2 s[12:13], s[0:1], 32
    s_cmp_ge_u32 s2, 512
    s_cbranch_scc1 L_end
    s_lshl_b32 s3, s2, 14
    v_lshlrev_b32 v2, 4, v0
    v_add_u32 v1, s3, v2
    v_and_b32 v2, 0x7ff, v2
    s_mov_b32 s24, 0x3f8e38e4
    s_mov_b32 s25, 0xffff0000
    s_waitcnt lgkmcnt(0)
    global_load_dwordx4 v[4:7], v2, s[6:7]
    global_load_dwordx4 v[8:11], v1, s[4:5] nt
    global_load_dwordx4 v[12:15], v1, s[8:9] nt
    global_load_dwordx4 v[16:19], v1, s[10:11] nt
    s_waitcnt vmcnt(3)
    v_lshlrev_b32 v20, 16, v4
    v_and_b32 v21, s25, v4
    v_lshlrev_b32 v22, 16, v5
    v_and_b32 v23, s25, v5
    v_lshlrev_b32 v24, 16, v6
    v_and_b32 v25, s25, v6
    v_lshlrev_b32 v26, 16, v7
    v_and_b32 v27, s25, v7
    s_waitcnt vmcnt(2)
    v_lshlrev_b32 v28, 16, v8
    v_and_b32 v29, s25, v8
    v_lshlrev_b32 v30, 16, v9
    v_and_b32 v31, s25, v9
    v_lshlrev_b32 v32, 16, v10
    v_and_b32 v33, s25, v10
    v_lshlrev_b32 v34, 16, v11
    v_and_b32 v35, s25, v11
    v_pk_add_f32 v[28:29], v[28:29], v[20:21]
    v_pk_add_f32 v[30:31], v[30:31], v[22:23]
    v_pk_add_f32 v[32:33], v[32:33], v[24:25]
    v_pk_add_f32 v[34:35], v[34:35], v[26:27]
    v_cvt_pk_bf16_f32 v28, 0, v28
    v_cvt_pk_bf16_f32 v29, 0, v29
    v_cvt_pk_bf16_f32 v30, 0, v30
    v_cvt_pk_bf16_f32 v31, 0, v31
    v_cvt_pk_bf16_f32 v32, 0, v32
    v_cvt_pk_bf16_f32 v33, 0, v33
    v_cvt_pk_bf16_f32 v34, 0, v34
    v_cvt_pk_bf16_f32 v35, 0, v35
    s_waitcnt vmcnt(1)
    v_lshlrev_b32 v8, 16, v12
    v_and_b32 v9, s25, v12
    v_lshlrev_b32 v10, 16, v13
    v_and_b32 v11, s25, v13
    v_lshlrev_b32 v36, 16, v14
    v_and_b32 v37, s25, v14
    v_lshlrev_b32 v38, 16, v15
    v_and_b32 v39, s25, v15
    v_pk_mul_f32 v[28:29], v[28:29], v[8:9]
    v_pk_mul_f32 v[30:31], v[30:31], v[10:11]
    v_pk_mul_f32 v[32:33], v[32:33], v[36:37]
    v_pk_mul_f32 v[34:35], v[34:35], v[38:39]
    v_cvt_pk_bf16_f32 v28, 0, v28
    v_cvt_pk_bf16_f32 v29, 0, v29
    v_cvt_pk_bf16_f32 v30, 0, v30
    v_cvt_pk_bf16_f32 v31, 0, v31
    v_cvt_pk_bf16_f32 v32, 0, v32
    v_cvt_pk_bf16_f32 v33, 0, v33
    v_cvt_pk_bf16_f32 v34, 0, v34
    v_cvt_pk_bf16_f32 v35, 0, v35
    v_pk_mul_f32 v[28:29], v[28:29], s[24:25] op_sel_hi:[1,0]
    v_pk_mul_f32 v[30:31], v[30:31], s[24:25] op_sel_hi:[1,0]
    v_pk_mul_f32 v[32:33], v[32:33], s[24:25] op_sel_hi:[1,0]
    v_pk_mul_f32 v[34:35], v[34:35], s[24:25] op_sel_hi:[1,0]
    v_cvt_pk_bf16_f32 v28, 0, v28
    v_cvt_pk_bf16_f32 v29, 0, v29
    v_cvt_pk_bf16_f32 v30, 0, v30
    v_cvt_pk_bf16_f32 v31, 0, v31
    v_cvt_pk_bf16_f32 v32, 0, v32
    v_cvt_pk_bf16_f32 v33, 0, v33
    v_cvt_pk_bf16_f32 v34, 0, v34
    v_cvt_pk_bf16_f32 v35, 0, v35
    s_waitcnt vmcnt(0)
    v_lshlrev_b32 v8, 16, v16
    v_and_b32 v9, s25, v16
    v_lshlrev_b32 v10, 16, v17
    v_and_b32 v11, s25, v17
    v_lshlrev_b32 v12, 16, v18
    v_and_b32 v13, s25, v18
    v_lshlrev_b32 v14, 16, v19
    v_and_b32 v15, s25, v19
    v_pk_add_f32 v[28:29], v[28:29], v[8:9]
    v_pk_add_f32 v[30:31], v[30:31], v[10:11]
    v_pk_add_f32 v[32:33], v[32:33], v[12:13]
    v_pk_add_f32 v[34:35], v[34:35], v[14:15]
    v_cvt_pk_bf16_f32 v16, v28, v29
    v_cvt_pk_bf16_f32 v17, v30, v31
    v_cvt_pk_bf16_f32 v18, v32, v33
    v_cvt_pk_bf16_f32 v19, v34, v35
    global_store_dwordx4 v1, v[16:19], s[12:13]
L_end:
    s_endpgm
.section .rodata,"a"
.p2align 6
.amdhsa_kernel standalone__fused_bias_dropout_add__prompt_kernel
  .amdhsa_next_free_vgpr 40
  .amdhsa_next_free_sgpr 26
  .amdhsa_accum_offset 40
  .amdhsa_group_segment_fixed_size 0
  .amdhsa_kernarg_size 56
  .amdhsa_user_sgpr_count 2
  .amdhsa_user_sgpr_kernarg_segment_ptr 1
  .amdhsa_system_sgpr_workgroup_id_x 1
  .amdhsa_float_denorm_mode_32 3
  .amdhsa_float_denorm_mode_16_64 3
.end_amdhsa_kernel
```
